```python
import torch

def _softmax(x, axis=-1):
    return torch.softmax(x, dim=axis)
def _gelu(x):
    return torch.nn.functional.gelu(x, approximate="tanh")
def _silu(x):
    return torch.nn.functional.silu(x)
def _sigmoid(x):
    return torch.sigmoid(x)
def _layernorm(x, axis=-1, eps=1e-5):
    m = x.mean(dim=axis, keepdim=True)
    v = x.var(dim=axis, keepdim=True, unbiased=False)
    return (x - m) / torch.sqrt(v + eps)
def _scatter_add(tgt, idx, src, axis=0):
    return tgt.clone().index_add_(axis, idx, src)
def _segment_sum(src, seg, n):
    out = torch.zeros((n,) + src.shape[1:], dtype=src.dtype)
    return out.index_add_(0, seg, src)
def _pad(x, pw):
    flat = tuple(v for pair in reversed(pw) for v in pair)
    return torch.nn.functional.pad(x, flat)

kernel_name = 'concat_heads__gqa_block_cached__gqa_block_cached__decode'

def setup_inputs():

    _w = (lambda a: (lambda t: t.to(torch.bfloat16) if t.is_floating_point() else t)(torch.as_tensor(a)))
    def _A_setup():
        B, Sq, D = 1, 1, 512
        Hq, Hkv, Sk, Dh = 32, 32, 4096, 128
        assert Hq % Hkv == 0, (Hq, Hkv)
        return {
            "x": _w((lambda *s: torch.randn(*s, dtype=torch.bfloat16) * 0.8)(B, Sq, D)),
            "k_cache": _w((lambda *s: torch.randn(*s, dtype=torch.bfloat16) * 1.6)(B, Hkv, Sk, Dh)),
            "v_cache": _w((lambda *s: torch.randn(*s, dtype=torch.bfloat16) * 0.2)(B, Hkv, Sk, Dh)),
            "wq": _w((lambda *s: torch.randn(*s, dtype=torch.bfloat16) * 1.6)(D, Hq * Dh) * (D ** -0.5)),
            "wo": _w((lambda *s: torch.randn(*s, dtype=torch.bfloat16) * 0.2)(Hq * Dh, D) * ((Hq * Dh) ** -0.5)),
        }
    _A_in = _A_setup()

    def _B_setup():
        B, Sq, D = 1, 1, 512
        Hq, Hkv, Sk, Dh = 32, 32, 4096, 128
        assert Hq % Hkv == 0, (Hq, Hkv)
        return {
            "x": _w((lambda *s: torch.randn(*s, dtype=torch.bfloat16) * 0.8)(B, Sq, D)),
            "k_cache": _w((lambda *s: torch.randn(*s, dtype=torch.bfloat16) * 1.6)(B, Hkv, Sk, Dh)),
            "v_cache": _w((lambda *s: torch.randn(*s, dtype=torch.bfloat16) * 0.2)(B, Hkv, Sk, Dh)),
            "wq": _w((lambda *s: torch.randn(*s, dtype=torch.bfloat16) * 1.6)(D, Hq * Dh) * (D ** -0.5)),
            "wo": _w((lambda *s: torch.randn(*s, dtype=torch.bfloat16) * 0.2)(Hq * Dh, D) * ((Hq * Dh) ** -0.5)),
        }
    _B_in = _B_setup()

    return {
        "A_x": _A_in["x"],
        "A_k_cache": _A_in["k_cache"],
        "A_v_cache": _A_in["v_cache"],
        "A_wq": _A_in["wq"],
        "A_wo": _A_in["wo"],
        "B_x": _B_in["x"],
        "B_k_cache": _B_in["k_cache"],
        "B_v_cache": _B_in["v_cache"],
        "B_wq": _B_in["wq"],
        "B_wo": _B_in["wo"],
    }

def reference(A_x, A_k_cache, A_v_cache, A_wq, A_wo, B_x, B_k_cache, B_v_cache, B_wq, B_wo):
    def _A_ref(x, k_cache, v_cache, wq, wo):
        B, Sq, D = x.shape
        Hq, Dh = 32, 128
        Hkv = k_cache.shape[1]
        rep = Hq // Hkv
        q = (lambda x, *d: x.permute(*d))((x @ wq).reshape(B, Sq, Hq, Dh), 0, 2, 1, 3)
        k = (lambda x, n, axis: torch.repeat_interleave(x, n, dim=axis))(k_cache, rep, axis=1)
        v = (lambda x, n, axis: torch.repeat_interleave(x, n, dim=axis))(v_cache, rep, axis=1)
        scores = torch.einsum("bhqd,bhkd->bhqk", q, k) * (Dh ** -0.5)
        p = _softmax(scores, axis=-1)
        o = torch.einsum("bhqk,bhkd->bhqd", p, v)
        return (lambda x, *d: x.permute(*d))(o, 0, 2, 1, 3).reshape(B, Sq, Hq * Dh) @ wo

    def _B_ref(x, k_cache, v_cache, wq, wo):
        B, Sq, D = x.shape
        Hq, Dh = 32, 128
        Hkv = k_cache.shape[1]
        rep = Hq // Hkv
        q = (lambda x, *d: x.permute(*d))((x @ wq).reshape(B, Sq, Hq, Dh), 0, 2, 1, 3)
        k = (lambda x, n, axis: torch.repeat_interleave(x, n, dim=axis))(k_cache, rep, axis=1)
        v = (lambda x, n, axis: torch.repeat_interleave(x, n, dim=axis))(v_cache, rep, axis=1)
        scores = torch.einsum("bhqd,bhkd->bhqk", q, k) * (Dh ** -0.5)
        p = _softmax(scores, axis=-1)
        o = torch.einsum("bhqk,bhkd->bhqd", p, v)
        return (lambda x, *d: x.permute(*d))(o, 0, 2, 1, 3).reshape(B, Sq, Hq * Dh) @ wo

    a = _A_ref(A_x, A_k_cache, A_v_cache, A_wq, A_wo)
    b = _B_ref(B_x, B_k_cache, B_v_cache, B_wq, B_wo)
    return torch.concatenate([a, b], axis=-1)
```

```asm
; @launch grid=(256,1,1) block=(512,1,1) lds=140672
.amdgcn_target "amdgcn-amd-amdhsa--gfx950"
.text
.globl concat_heads__gqa_block_cached__gqa_block_cached__decode_kernel
.p2align 8
.type concat_heads__gqa_block_cached__gqa_block_cached__decode_kernel,@function
concat_heads__gqa_block_cached__gqa_block_cached__decode_kernel:
    s_cmpk_ge_u32 s2, 0x100
    s_cbranch_scc1 L_end
    s_lshr_b32 s6, s2, 5
    s_and_b32 s6, s6, 1
    s_mul_i32 s3, s6, 40
    s_load_dwordx8 s[8:15], s[0:1], s3
    s_setprio 3
    v_lshrrev_b32 v6, 6, v0
    s_add_u32 s5, s2, s6
    s_and_b32 s5, s5, 7
    v_readfirstlane_b32 s7, v6
    s_lshr_b32 s43, s2, 3
    s_and_b32 s4, s43, 3
    s_lshl2_add_u32 s5, s5, s4
    s_lshr_b32 s4, s2, 6
    v_and_b32 v6, 15, v0
    v_bfe_u32 v7, v0, 4, 2
    v_lshlrev_b32 v2, 4, v6
    v_lshl_add_u32 v3, v7, 17, v2
    s_lshl_b32 s41, s7, 19
    s_lshl_b32 s42, s5, 8
    s_add_u32 s41, s41, s42
    s_lshl_b32 s42, s4, 15
    s_add_u32 s52, s41, s42
    s_lshl_b32 s22, 1, 22
    s_lshl_b32 s23, 1, 17
    s_waitcnt lgkmcnt(0)
    s_mov_b64 s[20:21], s[14:15]
    buffer_load_dwordx4 v[64:67], v3, s[20:23], s52 offen
    s_addk_i32 s52, 0x2000
    buffer_load_dwordx4 v[68:71], v3, s[20:23], s52 offen
    s_addk_i32 s52, 0x2000
    buffer_load_dwordx4 v[72:75], v3, s[20:23], s52 offen
    s_addk_i32 s52, 0x2000
    buffer_load_dwordx4 v[76:79], v3, s[20:23], s52 offen
    s_mov_b64 s[16:17], s[12:13]
    s_mov_b64 s[12:13], s[10:11]
    s_movk_i32 s10, 0x400
    s_mov_b32 s11, s23
    v_lshlrev_b32 v5, 5, v7
    s_lshl_b32 s42, s7, 7
    s_lshl3_add_u32 s48, s4, s42
    buffer_load_dwordx2 v[32:33], v5, s[8:11], s48 offen
    s_lshl_b32 s14, 1, 25
    s_mov_b32 s15, s23
    v_lshl_add_u32 v2, v7, 10, v2
    s_lshl2_add_u32 s56, s5, s4
    s_lshl3_add_u32 s40, s56, s7
    s_lshl_b32 s40, s40, 15
    s_add_u32 s43, s43, s2
    s_add_u32 s43, s43, s7
    s_and_b32 s94, s43, 7
    s_lshl_b32 s94, s94, 12
    s_add_u32 s94, s94, s40
    buffer_load_dwordx4 v[128:131], v2, s[12:15], s94 offen offset:0 nt
    buffer_load_dwordx4 v[132:135], v2, s[12:15], s94 offen offset:256 nt
    buffer_load_dwordx4 v[136:139], v2, s[12:15], s94 offen offset:512 nt
    buffer_load_dwordx4 v[140:143], v2, s[12:15], s94 offen offset:768 nt
    s_add_u32 s3, s3, 32
    s_load_dwordx2 s[24:25], s[0:1], s3
    s_load_dwordx2 s[28:29], s[0:1], 80
    s_load_dwordx2 s[32:33], s[0:1], 88
    s_load_dwordx2 s[36:37], s[0:1], 96
    s_mov_b32 s44, s4
    s_add_u32 s3, s4, 1
    s_and_b32 s45, s3, 3
    s_lshl3_add_u32 s49, s45, s42
    buffer_load_dwordx2 v[34:35], v5, s[8:11], s49 offen
    s_lshl_b32 s3, s45, 15
    s_add_u32 s53, s41, s3
    s_add_u32 s3, s4, 2
    s_and_b32 s46, s3, 3
    s_lshl3_add_u32 s50, s46, s42
    buffer_load_dwordx2 v[36:37], v5, s[8:11], s50 offen
    s_lshl_b32 s3, s46, 15
    s_add_u32 s54, s41, s3
    s_add_u32 s3, s4, 3
    s_and_b32 s47, s3, 3
    s_lshl3_add_u32 s51, s47, s42
    buffer_load_dwordx2 v[38:39], v5, s[8:11], s51 offen
    s_lshl_b32 s3, s47, 15
    s_add_u32 s55, s41, s3
    s_add_u32 s3, s43, 1
    s_and_b32 s3, s3, 7
    s_lshl_b32 s3, s3, 12
    s_add_u32 s95, s40, s3
    s_add_u32 s3, s43, 2
    s_and_b32 s3, s3, 7
    s_lshl_b32 s3, s3, 12
    s_add_u32 s96, s40, s3
    s_add_u32 s3, s43, 3
    s_and_b32 s3, s3, 7
    s_lshl_b32 s3, s3, 12
    s_add_u32 s97, s40, s3
    s_add_u32 s3, s43, 4
    s_and_b32 s3, s3, 7
    s_lshl_b32 s3, s3, 12
    s_add_u32 s98, s40, s3
    s_add_u32 s3, s43, 5
    s_and_b32 s3, s3, 7
    s_lshl_b32 s3, s3, 12
    s_add_u32 s99, s40, s3
    s_add_u32 s3, s43, 6
    s_and_b32 s3, s3, 7
    s_lshl_b32 s3, s3, 12
    s_add_u32 s100, s40, s3
    s_add_u32 s3, s43, 7
    s_and_b32 s3, s3, 7
    s_lshl_b32 s3, s3, 12
    s_add_u32 s101, s40, s3
    v_and_b32 v0, 63, v0
    s_mov_b64 s[18:19], s[14:15]
    s_mov_b64 s[26:27], s[22:23]
    s_mov_b64 s[38:39], s[22:23]
    s_movk_i32 s30, 0x800
    s_mov_b32 s31, s23
    s_movk_i32 s34, 0x100
    s_mov_b32 s35, s23
    s_lshl_b32 s56, s5, 2
    s_add_u32 s56, s56, s4
    s_lshl_b32 s58, s6, 18
    s_lshl_b32 s3, s7, 15
    s_add_u32 s58, s58, s3
    s_lshl_b32 s3, s56, 7
    s_add_u32 s58, s58, s3
    s_lshl_b32 s59, s6, 7
    s_add_u32 s59, s59, s56
    s_lshl_b32 s59, s59, 3
    s_add_u32 s59, s59, 524288
    s_mov_b32 s60, 0x11111111
    s_mov_b32 s61, 0x11111111
    v_lshrrev_b32 v63, 5, v0
    v_lshlrev_b32 v63, 14, v63
    v_and_b32 v62, 31, v0
    v_lshl_add_u32 v62, v62, 2, v63
    v_mov_b32 v12, -1
    v_mov_b32 v13, -1
    v_mov_b32 v14, -1
    v_mov_b32 v15, -1
    s_waitcnt lgkmcnt(0)
    s_mov_b64 exec, s[60:61]
    buffer_store_dwordx4 v[12:15], v62, s[36:39], s58 offen sc0 sc1
    s_mov_b64 exec, -1
    s_cmp_lg_u32 s7, 0
    s_cbranch_scc1 L_noclr
    s_mov_b64 exec, 1
    buffer_store_dwordx2 v[12:13], off, s[36:39], s59 sc0 sc1
    s_mov_b64 exec, -1
L_noclr:
    v_and_b32 v16, 1, v6
    v_lshlrev_b32 v16, 4, v16
    s_mov_b32 s3, 0xffff
    v_lshlrev_b32 v16, v16, s3
    v_lshrrev_b32 v17, 1, v6
    v_cmp_eq_u32 vcc, 0, v17
    s_nop 1
    v_cndmask_b32 v8, 0, v16, vcc
    v_cmp_eq_u32 vcc, 1, v17
    s_nop 1
    v_cndmask_b32 v9, 0, v16, vcc
    v_cmp_eq_u32 vcc, 2, v17
    s_nop 1
    v_cndmask_b32 v10, 0, v16, vcc
    v_cmp_eq_u32 vcc, 3, v17
    s_nop 1
    v_cndmask_b32 v11, 0, v16, vcc
    v_lshrrev_b32 v16, 3, v0
    v_and_b32 v17, 7, v0
    v_lshlrev_b32 v4, 10, v16
    v_lshl_add_u32 v4, v17, 4, v4
    s_lshl_b32 s62, s5, 17
    s_lshl_b32 s3, s7, 7
    s_add_u32 s62, s62, s3
    s_lshl_b32 s63, s7, 14
    s_mov_b32 s64, 0x01000100
    s_mov_b32 s65, 0x03020302
    s_lshl_b32 s3, s7, 9
    s_add_u32 s3, s3, 131072
    v_lshlrev_b32 v60, 7, v7
    v_lshl_add_u32 v60, v6, 2, v60
    v_add_u32 v60, s3, v60
    v_lshlrev_b32 v61, 3, v0
    v_add_u32 v61, 131072, v61
    s_lshl_b32 s3, s7, 8
    s_add_u32 s3, s3, 135168
    v_lshl_add_u32 v59, v0, 2, s3
    v_lshl_add_u32 v58, v6, 4, s3
    s_mov_b32 s66, 0x00ff00ff
    s_mov_b32 s67, 0x00ff00ff
    s_waitcnt vmcnt(8)
    v_perm_b32 v40, v32, v32, s64
    v_perm_b32 v41, v32, v32, s65
    v_perm_b32 v42, v33, v33, s64
    v_perm_b32 v43, v33, v33, s65
    v_and_b32 v16, v40, v8
    v_and_b32 v17, v40, v9
    v_and_b32 v18, v40, v10
    v_and_b32 v19, v40, v11
    s_waitcnt vmcnt(12)
    s_nop 0
    v_mfma_f32_16x16x32_bf16 v[12:15], v[64:67], v[16:19], 0
    v_and_b32 v20, v41, v8
    v_and_b32 v21, v41, v9
    v_and_b32 v22, v41, v10
    v_and_b32 v23, v41, v11
    s_waitcnt vmcnt(11)
    s_nop 0
    v_mfma_f32_16x16x32_bf16 v[12:15], v[68:71], v[20:23], v[12:15]
    v_and_b32 v24, v42, v8
    v_and_b32 v25, v42, v9
    v_and_b32 v26, v42, v10
    v_and_b32 v27, v42, v11
    s_waitcnt vmcnt(10)
    s_nop 0
    v_mfma_f32_16x16x32_bf16 v[12:15], v[72:75], v[24:27], v[12:15]
    v_and_b32 v28, v43, v8
    v_and_b32 v29, v43, v9
    v_and_b32 v30, v43, v10
    v_and_b32 v31, v43, v11
    s_waitcnt vmcnt(9)
    s_nop 0
    v_mfma_f32_16x16x32_bf16 v[12:15], v[76:79], v[28:31], v[12:15]
    s_waitcnt vmcnt(1)
    v_mov_b32 v5, v62
    v_perm_b32 v44, v34, v34, s64
    v_perm_b32 v45, v34, v34, s65
    v_perm_b32 v46, v35, v35, s64
    v_perm_b32 v47, v35, v35, s65
    v_perm_b32 v48, v36, v36, s64
    v_perm_b32 v49, v36, v36, s65
    v_perm_b32 v50, v37, v37, s64
    v_perm_b32 v51, v37, v37, s65
    v_perm_b32 v52, v38, v38, s64
    v_perm_b32 v53, v38, v38, s65
    v_perm_b32 v54, v39, v39, s64
    v_perm_b32 v55, v39, v39, s65
    s_setprio 0
    s_waitcnt vmcnt(5)
    buffer_load_dwordx4 v[144:147], v2, s[12:15], s95 offen offset:0 nt
    s_waitcnt vmcnt(5)
    buffer_load_dwordx4 v[148:151], v2, s[12:15], s95 offen offset:256 nt
    s_waitcnt vmcnt(5)
    buffer_load_dwordx4 v[80:83], v3, s[20:23], s53 offen
    s_waitcnt vmcnt(5)
    buffer_load_dwordx4 v[152:155], v2, s[12:15], s95 offen offset:512 nt
    s_addk_i32 s53, 0x2000
    buffer_load_dwordx4 v[84:87], v3, s[20:23], s53 offen
    s_waitcnt vmcnt(6)
    buffer_load_dwordx4 v[156:159], v2, s[12:15], s95 offen offset:768 nt
    s_waitcnt vmcnt(6)
    buffer_load_dwordx4 v[160:163], v2, s[12:15], s96 offen offset:0 nt
    s_addk_i32 s53, 0x2000
    buffer_load_dwordx4 v[88:91], v3, s[20:23], s53 offen
    s_waitcnt vmcnt(7)
    buffer_load_dwordx4 v[164:167], v2, s[12:15], s96 offen offset:256 nt
    s_addk_i32 s53, 0x2000
    buffer_load_dwordx4 v[92:95], v3, s[20:23], s53 offen
    s_waitcnt vmcnt(8)
    buffer_load_dwordx4 v[168:171], v2, s[12:15], s96 offen offset:512 nt
    s_waitcnt vmcnt(7)
    buffer_load_dwordx4 v[172:175], v2, s[12:15], s96 offen offset:768 nt
    v_and_b32 v16, v44, v8
    v_and_b32 v17, v44, v9
    v_and_b32 v18, v44, v10
    v_and_b32 v19, v44, v11
    s_nop 1
    v_mfma_f32_16x16x32_bf16 v[12:15], v[80:83], v[16:19], v[12:15]
    buffer_load_dwordx4 v[96:99], v3, s[20:23], s54 offen
    s_waitcnt vmcnt(7)
    buffer_load_dwordx4 v[176:179], v2, s[12:15], s97 offen offset:0 nt
    v_and_b32 v20, v45, v8
    v_and_b32 v21, v45, v9
    v_and_b32 v22, v45, v10
    v_and_b32 v23, v45, v11
    s_nop 1
    v_mfma_f32_16x16x32_bf16 v[12:15], v[84:87], v[20:23], v[12:15]
    s_addk_i32 s54, 0x2000
    buffer_load_dwordx4 v[100:103], v3, s[20:23], s54 offen
    s_waitcnt vmcnt(8)
    buffer_load_dwordx4 v[180:183], v2, s[12:15], s97 offen offset:256 nt
    s_waitcnt vmcnt(7)
    buffer_load_dwordx4 v[184:187], v2, s[12:15], s97 offen offset:512 nt
    v_and_b32 v24, v46, v8
    v_and_b32 v25, v46, v9
    v_and_b32 v26, v46, v10
    v_and_b32 v27, v46, v11
    s_nop 1
    v_mfma_f32_16x16x32_bf16 v[12:15], v[88:91], v[24:27], v[12:15]
    s_addk_i32 s54, 0x2000
    buffer_load_dwordx4 v[104:107], v3, s[20:23], s54 offen
    s_waitcnt vmcnt(7)
    buffer_load_dwordx4 v[188:191], v2, s[12:15], s97 offen offset:768 nt
    v_and_b32 v28, v47, v8
    v_and_b32 v29, v47, v9
    v_and_b32 v30, v47, v10
    v_and_b32 v31, v47, v11
    s_nop 1
    v_mfma_f32_16x16x32_bf16 v[12:15], v[92:95], v[28:31], v[12:15]
    s_addk_i32 s54, 0x2000
    buffer_load_dwordx4 v[108:111], v3, s[20:23], s54 offen
    s_waitcnt vmcnt(8)
    buffer_load_dwordx4 v[192:195], v2, s[12:15], s98 offen offset:0 nt
    s_waitcnt vmcnt(7)
    buffer_load_dwordx4 v[196:199], v2, s[12:15], s98 offen offset:256 nt
    v_and_b32 v16, v48, v8
    v_and_b32 v17, v48, v9
    v_and_b32 v18, v48, v10
    v_and_b32 v19, v48, v11
    s_nop 1
    v_mfma_f32_16x16x32_bf16 v[12:15], v[96:99], v[16:19], v[12:15]
    buffer_load_dwordx4 v[112:115], v3, s[20:23], s55 offen
    s_waitcnt vmcnt(7)
    buffer_load_dwordx4 v[200:203], v2, s[12:15], s98 offen offset:512 nt
    v_and_b32 v20, v49, v8
    v_and_b32 v21, v49, v9
    v_and_b32 v22, v49, v10
    v_and_b32 v23, v49, v11
    s_nop 1
    v_mfma_f32_16x16x32_bf16 v[12:15], v[100:103], v[20:23], v[12:15]
    s_addk_i32 s55, 0x2000
    buffer_load_dwordx4 v[116:119], v3, s[20:23], s55 offen
    s_waitcnt vmcnt(8)
    buffer_load_dwordx4 v[204:207], v2, s[12:15], s98 offen offset:768 nt
    s_waitcnt vmcnt(7)
    buffer_load_dwordx4 v[208:211], v2, s[12:15], s99 offen offset:0 nt
    v_and_b32 v24, v50, v8
    v_and_b32 v25, v50, v9
    v_and_b32 v26, v50, v10
    v_and_b32 v27, v50, v11
    s_nop 1
    v_mfma_f32_16x16x32_bf16 v[12:15], v[104:107], v[24:27], v[12:15]
    s_addk_i32 s55, 0x2000
    buffer_load_dwordx4 v[120:123], v3, s[20:23], s55 offen
    s_waitcnt vmcnt(7)
    buffer_load_dwordx4 v[212:215], v2, s[12:15], s99 offen offset:256 nt
    v_and_b32 v28, v51, v8
    v_and_b32 v29, v51, v9
    v_and_b32 v30, v51, v10
    v_and_b32 v31, v51, v11
    s_nop 1
    v_mfma_f32_16x16x32_bf16 v[12:15], v[108:111], v[28:31], v[12:15]
    s_addk_i32 s55, 0x2000
    buffer_load_dwordx4 v[124:127], v3, s[20:23], s55 offen
    buffer_load_dwordx4 v[216:219], v2, s[12:15], s99 offen offset:512 nt
    buffer_load_dwordx4 v[220:223], v2, s[12:15], s99 offen offset:768 nt
    buffer_load_dwordx4 v[224:227], v2, s[12:15], s100 offen offset:0 nt
    buffer_load_dwordx4 v[228:231], v2, s[12:15], s100 offen offset:256 nt
    v_and_b32 v16, v52, v8
    v_and_b32 v17, v52, v9
    v_and_b32 v18, v52, v10
    v_and_b32 v19, v52, v11
    s_waitcnt vmcnt(11)
    s_nop 0
    v_mfma_f32_16x16x32_bf16 v[12:15], v[112:115], v[16:19], v[12:15]
    v_and_b32 v20, v53, v8
    v_and_b32 v21, v53, v9
    v_and_b32 v22, v53, v10
    v_and_b32 v23, v53, v11
    s_waitcnt vmcnt(9)
    s_nop 0
    v_mfma_f32_16x16x32_bf16 v[12:15], v[116:119], v[20:23], v[12:15]
    v_and_b32 v24, v54, v8
    v_and_b32 v25, v54, v9
    v_and_b32 v26, v54, v10
    v_and_b32 v27, v54, v11
    s_waitcnt vmcnt(6)
    s_nop 0
    v_mfma_f32_16x16x32_bf16 v[12:15], v[120:123], v[24:27], v[12:15]
    v_and_b32 v28, v55, v8
    v_and_b32 v29, v55, v9
    v_and_b32 v30, v55, v10
    v_and_b32 v31, v55, v11
    s_waitcnt vmcnt(4)
    s_nop 0
    v_mfma_f32_16x16x32_bf16 v[12:15], v[124:127], v[28:31], v[12:15]
    s_nop 7
    s_mov_b64 exec, s[66:67]
    ds_write_b32 v60, v12 offset:0
    ds_write_b32 v60, v13 offset:32
    ds_write_b32 v60, v14 offset:64
    ds_write_b32 v60, v15 offset:96
    s_mov_b64 exec, -1
    s_waitcnt lgkmcnt(0)
    s_barrier
    ds_read_b64 v[32:33], v61 offset:0
    ds_read_b64 v[34:35], v61 offset:512
    ds_read_b64 v[36:37], v61 offset:1024
    ds_read_b64 v[38:39], v61 offset:1536
    ds_read_b64 v[40:41], v61 offset:2048
    ds_read_b64 v[42:43], v61 offset:2560
    ds_read_b64 v[44:45], v61 offset:3072
    ds_read_b64 v[46:47], v61 offset:3584
    s_lshl_b32 s57, s6, 7
    s_cmp_lg_u32 s7, 0
    s_cbranch_scc1 L_nocnt
    v_mov_b32 v12, 1
    s_mov_b64 exec, 1
    buffer_atomic_add v12, off, s[32:35], s57 sc1
    s_mov_b64 exec, -1
L_nocnt:
    s_and_b32 s49, s2, 31
    s_lshr_b32 s3, s49, 4
    s_or_b32 s56, s3, s4
    s_or_b32 s48, s56, s7
    s_waitcnt lgkmcnt(6)
    v_add_f32 v32, v32, v34
    v_add_f32 v33, v33, v35
    s_waitcnt lgkmcnt(5)
    v_add_f32 v32, v32, v36
    v_add_f32 v33, v33, v37
    s_waitcnt lgkmcnt(4)
    v_add_f32 v32, v32, v38
    v_add_f32 v33, v33, v39
    s_waitcnt lgkmcnt(3)
    v_add_f32 v32, v32, v40
    v_add_f32 v33, v33, v41
    s_waitcnt lgkmcnt(2)
    v_add_f32 v32, v32, v42
    v_add_f32 v33, v33, v43
    s_waitcnt lgkmcnt(1)
    v_add_f32 v32, v32, v44
    v_add_f32 v33, v33, v45
    s_waitcnt lgkmcnt(0)
    v_add_f32 v32, v32, v46
    v_add_f32 v33, v33, v47
    v_cvt_pk_bf16_f32 v32, v32, v33
    ds_write_b32 v59, v32
    s_waitcnt lgkmcnt(0)
    ds_read_b128 v[16:19], v58
    v_xor_b32 v48, 0, v4
    v_xor_b32 v49, 32, v4
    v_xor_b32 v50, 64, v4
    v_xor_b32 v51, 96, v4
    s_mov_b32 s64, 0xcccccccc
    s_mov_b32 s65, 0xcccccccc
    s_mov_b32 s50, 0xaaaaaaaa
    s_mov_b32 s51, 0xaaaaaaaa
    s_waitcnt lgkmcnt(0)
    buffer_load_dwordx4 v[232:235], v2, s[12:15], s100 offen offset:512 nt
    v_dot2_f32_bf16 v12, v128, v16, 0
    v_dot2_f32_bf16 v13, v132, v16, 0
    v_dot2_f32_bf16 v14, v136, v16, 0
    v_dot2_f32_bf16 v15, v140, v16, 0
    v_dot2_f32_bf16 v12, v129, v17, v12
    v_dot2_f32_bf16 v13, v133, v17, v13
    v_dot2_f32_bf16 v14, v137, v17, v14
    v_dot2_f32_bf16 v15, v141, v17, v15
    v_dot2_f32_bf16 v12, v130, v18, v12
    v_dot2_f32_bf16 v13, v134, v18, v13
    v_dot2_f32_bf16 v14, v138, v18, v14
    v_dot2_f32_bf16 v15, v142, v18, v15
    v_dot2_f32_bf16 v12, v131, v19, v12
    v_dot2_f32_bf16 v13, v135, v19, v13
    v_dot2_f32_bf16 v14, v139, v19, v14
    v_dot2_f32_bf16 v15, v143, v19, v15
    s_nop 2
    v_add_f32_dpp v12, v12, v12 row_ror:8 row_mask:0xf bank_mask:0x3
    v_add_f32_dpp v14, v14, v14 row_ror:8 row_mask:0xf bank_mask:0x3
    v_add_f32_dpp v12, v13, v13 row_ror:8 row_mask:0xf bank_mask:0xc
    v_add_f32_dpp v14, v15, v15 row_ror:8 row_mask:0xf bank_mask:0xc
    s_nop 0
    v_add_f32_dpp v32, v12, v12 row_half_mirror row_mask:0xf bank_mask:0x5
    v_add_f32_dpp v32, v14, v14 row_half_mirror row_mask:0xf bank_mask:0xa
    buffer_load_dwordx4 v[236:239], v2, s[12:15], s100 offen offset:768 nt
    v_dot2_f32_bf16 v12, v144, v16, 0
    v_dot2_f32_bf16 v13, v148, v16, 0
    v_dot2_f32_bf16 v14, v152, v16, 0
    v_dot2_f32_bf16 v15, v156, v16, 0
    v_dot2_f32_bf16 v12, v145, v17, v12
    v_dot2_f32_bf16 v13, v149, v17, v13
    v_dot2_f32_bf16 v14, v153, v17, v14
    v_dot2_f32_bf16 v15, v157, v17, v15
    v_dot2_f32_bf16 v12, v146, v18, v12
    v_dot2_f32_bf16 v13, v150, v18, v13
    v_dot2_f32_bf16 v14, v154, v18, v14
    v_dot2_f32_bf16 v15, v158, v18, v15
    v_dot2_f32_bf16 v12, v147, v19, v12
    v_dot2_f32_bf16 v13, v151, v19, v13
    v_dot2_f32_bf16 v14, v155, v19, v14
    v_dot2_f32_bf16 v15, v159, v19, v15
    s_nop 2
    v_add_f32_dpp v12, v12, v12 row_ror:8 row_mask:0xf bank_mask:0x3
    v_add_f32_dpp v14, v14, v14 row_ror:8 row_mask:0xf bank_mask:0x3
    v_add_f32_dpp v12, v13, v13 row_ror:8 row_mask:0xf bank_mask:0xc
    v_add_f32_dpp v14, v15, v15 row_ror:8 row_mask:0xf bank_mask:0xc
    s_nop 0
    v_add_f32_dpp v33, v12, v12 row_half_mirror row_mask:0xf bank_mask:0x5
    v_add_f32_dpp v33, v14, v14 row_half_mirror row_mask:0xf bank_mask:0xa
    v_add_f32_dpp v32, v32, v32 quad_perm:[2,3,0,1] row_mask:0xf bank_mask:0xf
    s_nop 0
    v_add_f32_dpp v33, v33, v33 quad_perm:[2,3,0,1] row_mask:0xf bank_mask:0xf
    v_cndmask_b32 v40, v32, v33, s[64:65]
    s_waitcnt vmcnt(5)
    s_lshl_b32 s3, s44, 15
    s_add_u32 s68, s62, s3
    s_lshl_b32 s3, s44, 12
    s_add_u32 s69, s63, s3
    s_mov_b32 m0, s69
    s_nop 0
    buffer_load_dwordx4 v48, s[24:27], s68 offen  lds
    v_dot2_f32_bf16 v12, v160, v16, 0
    v_dot2_f32_bf16 v13, v164, v16, 0
    v_dot2_f32_bf16 v14, v168, v16, 0
    v_dot2_f32_bf16 v15, v172, v16, 0
    v_dot2_f32_bf16 v12, v161, v17, v12
    v_dot2_f32_bf16 v13, v165, v17, v13
    v_dot2_f32_bf16 v14, v169, v17, v14
    v_dot2_f32_bf16 v15, v173, v17, v15
    v_dot2_f32_bf16 v12, v162, v18, v12
    v_dot2_f32_bf16 v13, v166, v18, v13
    v_dot2_f32_bf16 v14, v170, v18, v14
    v_dot2_f32_bf16 v15, v174, v18, v15
    v_dot2_f32_bf16 v12, v163, v19, v12
    v_dot2_f32_bf16 v13, v167, v19, v13
    v_dot2_f32_bf16 v14, v171, v19, v14
    v_dot2_f32_bf16 v15, v175, v19, v15
    s_nop 2
    v_add_f32_dpp v12, v12, v12 row_ror:8 row_mask:0xf bank_mask:0x3
    v_add_f32_dpp v14, v14, v14 row_ror:8 row_mask:0xf bank_mask:0x3
    v_add_f32_dpp v12, v13, v13 row_ror:8 row_mask:0xf bank_mask:0xc
    v_add_f32_dpp v14, v15, v15 row_ror:8 row_mask:0xf bank_mask:0xc
    s_nop 0
    v_add_f32_dpp v34, v12, v12 row_half_mirror row_mask:0xf bank_mask:0x5
    v_add_f32_dpp v34, v14, v14 row_half_mirror row_mask:0xf bank_mask:0xa
    s_waitcnt vmcnt(5)
    buffer_load_dwordx4 v[240:243], v2, s[12:15], s101 offen offset:0 nt
    v_dot2_f32_bf16 v12, v176, v16, 0
    v_dot2_f32_bf16 v13, v180, v16, 0
    v_dot2_f32_bf16 v14, v184, v16, 0
    v_dot2_f32_bf16 v15, v188, v16, 0
    v_dot2_f32_bf16 v12, v177, v17, v12
    v_dot2_f32_bf16 v13, v181, v17, v13
    v_dot2_f32_bf16 v14, v185, v17, v14
    v_dot2_f32_bf16 v15, v189, v17, v15
    v_dot2_f32_bf16 v12, v178, v18, v12
    v_dot2_f32_bf16 v13, v182, v18, v13
    v_dot2_f32_bf16 v14, v186, v18, v14
    v_dot2_f32_bf16 v15, v190, v18, v15
    v_dot2_f32_bf16 v12, v179, v19, v12
    v_dot2_f32_bf16 v13, v183, v19, v13
    v_dot2_f32_bf16 v14, v187, v19, v14
    v_dot2_f32_bf16 v15, v191, v19, v15
    s_nop 2
    v_add_f32_dpp v12, v12, v12 row_ror:8 row_mask:0xf bank_mask:0x3
    v_add_f32_dpp v14, v14, v14 row_ror:8 row_mask:0xf bank_mask:0x3
    v_add_f32_dpp v12, v13, v13 row_ror:8 row_mask:0xf bank_mask:0xc
    v_add_f32_dpp v14, v15, v15 row_ror:8 row_mask:0xf bank_mask:0xc
    s_nop 0
    v_add_f32_dpp v35, v12, v12 row_half_mirror row_mask:0xf bank_mask:0x5
    v_add_f32_dpp v35, v14, v14 row_half_mirror row_mask:0xf bank_mask:0xa
    v_add_f32_dpp v34, v34, v34 quad_perm:[2,3,0,1] row_mask:0xf bank_mask:0xf
    s_nop 0
    v_add_f32_dpp v35, v35, v35 quad_perm:[2,3,0,1] row_mask:0xf bank_mask:0xf
    v_cndmask_b32 v41, v34, v35, s[64:65]
    v_add_f32_dpp v40, v40, v40 quad_perm:[1,0,3,2] row_mask:0xf bank_mask:0xf
    s_nop 0
    v_add_f32_dpp v41, v41, v41 quad_perm:[1,0,3,2] row_mask:0xf bank_mask:0xf
    v_cndmask_b32 v44, v40, v41, s[50:51]
    s_waitcnt vmcnt(5)
    buffer_load_dwordx4 v[244:247], v2, s[12:15], s101 offen offset:256 nt
    v_dot2_f32_bf16 v12, v192, v16, 0
    v_dot2_f32_bf16 v13, v196, v16, 0
    v_dot2_f32_bf16 v14, v200, v16, 0
    v_dot2_f32_bf16 v15, v204, v16, 0
    v_dot2_f32_bf16 v12, v193, v17, v12
    v_dot2_f32_bf16 v13, v197, v17, v13
    v_dot2_f32_bf16 v14, v201, v17, v14
    v_dot2_f32_bf16 v15, v205, v17, v15
    v_dot2_f32_bf16 v12, v194, v18, v12
    v_dot2_f32_bf16 v13, v198, v18, v13
    v_dot2_f32_bf16 v14, v202, v18, v14
    v_dot2_f32_bf16 v15, v206, v18, v15
    v_dot2_f32_bf16 v12, v195, v19, v12
    v_dot2_f32_bf16 v13, v199, v19, v13
    v_dot2_f32_bf16 v14, v203, v19, v14
    v_dot2_f32_bf16 v15, v207, v19, v15
    s_nop 2
    v_add_f32_dpp v12, v12, v12 row_ror:8 row_mask:0xf bank_mask:0x3
    v_add_f32_dpp v14, v14, v14 row_ror:8 row_mask:0xf bank_mask:0x3
    v_add_f32_dpp v12, v13, v13 row_ror:8 row_mask:0xf bank_mask:0xc
    v_add_f32_dpp v14, v15, v15 row_ror:8 row_mask:0xf bank_mask:0xc
    s_nop 0
    v_add_f32_dpp v36, v12, v12 row_half_mirror row_mask:0xf bank_mask:0x5
    v_add_f32_dpp v36, v14, v14 row_half_mirror row_mask:0xf bank_mask:0xa
    s_add_u32 s68, s68, 0x2000
    s_add_u32 s69, s69, 0x400
    s_mov_b32 m0, s69
    s_nop 0
    buffer_load_dwordx4 v49, s[24:27], s68 offen  lds
    v_dot2_f32_bf16 v12, v208, v16, 0
    v_dot2_f32_bf16 v13, v212, v16, 0
    v_dot2_f32_bf16 v14, v216, v16, 0
    v_dot2_f32_bf16 v15, v220, v16, 0
    v_dot2_f32_bf16 v12, v209, v17, v12
    v_dot2_f32_bf16 v13, v213, v17, v13
    v_dot2_f32_bf16 v14, v217, v17, v14
    v_dot2_f32_bf16 v15, v221, v17, v15
    v_dot2_f32_bf16 v12, v210, v18, v12
    v_dot2_f32_bf16 v13, v214, v18, v13
    v_dot2_f32_bf16 v14, v218, v18, v14
    v_dot2_f32_bf16 v15, v222, v18, v15
    v_dot2_f32_bf16 v12, v211, v19, v12
    v_dot2_f32_bf16 v13, v215, v19, v13
    v_dot2_f32_bf16 v14, v219, v19, v14
    v_dot2_f32_bf16 v15, v223, v19, v15
    s_nop 2
    v_add_f32_dpp v12, v12, v12 row_ror:8 row_mask:0xf bank_mask:0x3
    v_add_f32_dpp v14, v14, v14 row_ror:8 row_mask:0xf bank_mask:0x3
    v_add_f32_dpp v12, v13, v13 row_ror:8 row_mask:0xf bank_mask:0xc
    v_add_f32_dpp v14, v15, v15 row_ror:8 row_mask:0xf bank_mask:0xc
    s_nop 0
    v_add_f32_dpp v37, v12, v12 row_half_mirror row_mask:0xf bank_mask:0x5
    v_add_f32_dpp v37, v14, v14 row_half_mirror row_mask:0xf bank_mask:0xa
    v_add_f32_dpp v36, v36, v36 quad_perm:[2,3,0,1] row_mask:0xf bank_mask:0xf
    s_nop 0
    v_add_f32_dpp v37, v37, v37 quad_perm:[2,3,0,1] row_mask:0xf bank_mask:0xf
    v_cndmask_b32 v42, v36, v37, s[64:65]
    s_waitcnt vmcnt(6)
    buffer_load_dwordx4 v[248:251], v2, s[12:15], s101 offen offset:512 nt
    s_waitcnt vmcnt(6)
    buffer_load_dwordx4 v[252:255], v2, s[12:15], s101 offen offset:768 nt
    s_add_u32 s68, s68, 0x2000
    s_add_u32 s69, s69, 0x400
    s_mov_b32 m0, s69
    s_nop 0
    buffer_load_dwordx4 v50, s[24:27], s68 offen  lds
    buffer_load_dwordx4 v[128:131], v2, s[16:19], s94 offen offset:0 nt
    buffer_load_dwordx4 v[132:135], v2, s[16:19], s94 offen offset:256 nt
    s_waitcnt vmcnt(7)
    s_add_u32 s68, s68, 0x2000
    s_add_u32 s69, s69, 0x400
    s_mov_b32 m0, s69
    s_nop 0
    buffer_load_dwordx4 v51, s[24:27], s68 offen  lds
    v_dot2_f32_bf16 v12, v224, v16, 0
    v_dot2_f32_bf16 v13, v228, v16, 0
    v_dot2_f32_bf16 v14, v232, v16, 0
    v_dot2_f32_bf16 v15, v236, v16, 0
    v_dot2_f32_bf16 v12, v225, v17, v12
    v_dot2_f32_bf16 v13, v229, v17, v13
    v_dot2_f32_bf16 v14, v233, v17, v14
    v_dot2_f32_bf16 v15, v237, v17, v15
    v_dot2_f32_bf16 v12, v226, v18, v12
    v_dot2_f32_bf16 v13, v230, v18, v13
    v_dot2_f32_bf16 v14, v234, v18, v14
    v_dot2_f32_bf16 v15, v238, v18, v15
    v_dot2_f32_bf16 v12, v227, v19, v12
    v_dot2_f32_bf16 v13, v231, v19, v13
    v_dot2_f32_bf16 v14, v235, v19, v14
    v_dot2_f32_bf16 v15, v239, v19, v15
    s_nop 2
    v_add_f32_dpp v12, v12, v12 row_ror:8 row_mask:0xf bank_mask:0x3
    v_add_f32_dpp v14, v14, v14 row_ror:8 row_mask:0xf bank_mask:0x3
    v_add_f32_dpp v12, v13, v13 row_ror:8 row_mask:0xf bank_mask:0xc
    v_add_f32_dpp v14, v15, v15 row_ror:8 row_mask:0xf bank_mask:0xc
    s_nop 0
    v_add_f32_dpp v38, v12, v12 row_half_mirror row_mask:0xf bank_mask:0x5
    v_add_f32_dpp v38, v14, v14 row_half_mirror row_mask:0xf bank_mask:0xa
    buffer_load_dwordx4 v[136:139], v2, s[16:19], s94 offen offset:512 nt
    buffer_load_dwordx4 v[140:143], v2, s[16:19], s94 offen offset:768 nt
    s_waitcnt vmcnt(7)
    s_lshl_b32 s3, s45, 15
    s_add_u32 s68, s62, s3
    s_lshl_b32 s3, s45, 12
    s_add_u32 s69, s63, s3
    s_mov_b32 m0, s69
    s_nop 0
    buffer_load_dwordx4 v48, s[24:27], s68 offen  lds
    buffer_load_dwordx4 v[144:147], v2, s[16:19], s95 offen offset:0 nt
    buffer_load_dwordx4 v[148:151], v2, s[16:19], s95 offen offset:256 nt
    s_waitcnt vmcnt(7)
    s_add_u32 s68, s68, 0x2000
    s_add_u32 s69, s69, 0x400
    s_mov_b32 m0, s69
    s_nop 0
    buffer_load_dwordx4 v49, s[24:27], s68 offen  lds
    v_dot2_f32_bf16 v12, v240, v16, 0
    v_dot2_f32_bf16 v13, v244, v16, 0
    v_dot2_f32_bf16 v14, v248, v16, 0
    v_dot2_f32_bf16 v15, v252, v16, 0
    v_dot2_f32_bf16 v12, v241, v17, v12
    v_dot2_f32_bf16 v13, v245, v17, v13
    v_dot2_f32_bf16 v14, v249, v17, v14
    v_dot2_f32_bf16 v15, v253, v17, v15
    v_dot2_f32_bf16 v12, v242, v18, v12
    v_dot2_f32_bf16 v13, v246, v18, v13
    v_dot2_f32_bf16 v14, v250, v18, v14
    v_dot2_f32_bf16 v15, v254, v18, v15
    v_dot2_f32_bf16 v12, v243, v19, v12
    v_dot2_f32_bf16 v13, v247, v19, v13
    v_dot2_f32_bf16 v14, v251, v19, v14
    v_dot2_f32_bf16 v15, v255, v19, v15
    s_nop 2
    v_add_f32_dpp v12, v12, v12 row_ror:8 row_mask:0xf bank_mask:0x3
    v_add_f32_dpp v14, v14, v14 row_ror:8 row_mask:0xf bank_mask:0x3
    v_add_f32_dpp v12, v13, v13 row_ror:8 row_mask:0xf bank_mask:0xc
    v_add_f32_dpp v14, v15, v15 row_ror:8 row_mask:0xf bank_mask:0xc
    s_nop 0
    v_add_f32_dpp v39, v12, v12 row_half_mirror row_mask:0xf bank_mask:0x5
    v_add_f32_dpp v39, v14, v14 row_half_mirror row_mask:0xf bank_mask:0xa
    v_add_f32_dpp v38, v38, v38 quad_perm:[2,3,0,1] row_mask:0xf bank_mask:0xf
    s_nop 0
    v_add_f32_dpp v39, v39, v39 quad_perm:[2,3,0,1] row_mask:0xf bank_mask:0xf
    v_cndmask_b32 v43, v38, v39, s[64:65]
    v_add_f32_dpp v42, v42, v42 quad_perm:[1,0,3,2] row_mask:0xf bank_mask:0xf
    s_nop 0
    v_add_f32_dpp v43, v43, v43 quad_perm:[1,0,3,2] row_mask:0xf bank_mask:0xf
    v_cndmask_b32 v45, v42, v43, s[50:51]
    v_max_f32 v12, v44, v45
    s_nop 1
    v_max_f32_dpp v12, v12, v12 row_ror:8 row_mask:0xf bank_mask:0xf
    s_nop 1
    v_max_f32_dpp v12, v12, v12 row_ror:4 row_mask:0xf bank_mask:0xf
    s_nop 1
    v_max_f32_dpp v12, v12, v12 row_ror:2 row_mask:0xf bank_mask:0xf
    s_nop 1
    v_max_f32_dpp v12, v12, v12 row_ror:1 row_mask:0xf bank_mask:0xf
    v_mov_b32 v13, v12
    s_nop 1
    v_permlane16_swap_b32 v12, v13
    v_max_f32 v12, v12, v13
    v_mov_b32 v13, v12
    s_nop 1
    v_permlane32_swap_b32 v12, v13
    v_max_f32 v12, v12, v13
    s_lshl_b32 s3, s7, 2
    s_add_u32 s3, s3, 137216
    v_mov_b32 v6, s3
    v_and_b32 v7, 16, v0
    v_add_u32 v7, 137216, v7
    s_mov_b32 s64, 0x3e0293ee
    v_mul_f32 v14, s64, v12
    ds_write_b32 v6, v14
    v_fma_f32 v44, v44, s64, -v14
    v_fma_f32 v45, v45, s64, -v14
    v_exp_f32 v44, v44
    v_exp_f32 v45, v45
    s_nop 0
    v_add_f32 v12, v44, v45
    v_cvt_pk_bf16_f32 v46, v44, v44
    v_cvt_pk_bf16_f32 v47, v45, v45
    s_nop 1
    v_add_f32_dpp v12, v12, v12 row_ror:8 row_mask:0xf bank_mask:0xf
    s_nop 1
    v_add_f32_dpp v12, v12, v12 row_ror:4 row_mask:0xf bank_mask:0xf
    s_nop 1
    v_add_f32_dpp v12, v12, v12 row_ror:2 row_mask:0xf bank_mask:0xf
    s_nop 1
    v_add_f32_dpp v12, v12, v12 row_ror:1 row_mask:0xf bank_mask:0xf
    v_mov_b32 v13, v12
    s_nop 1
    v_permlane16_swap_b32 v12, v13
    v_add_f32 v12, v12, v13
    v_mov_b32 v13, v12
    s_nop 1
    v_permlane32_swap_b32 v12, v13
    v_add_f32 v12, v12, v13
    ds_write_b32 v6, v12 offset:32
    v_and_b32 v16, 15, v0
    v_lshrrev_b32 v17, 4, v0
    v_lshrrev_b32 v19, 2, v16
    v_lshlrev_b32 v18, 10, v19
    v_lshl_add_u32 v18, v19, 5, v18
    v_lshl_add_u32 v18, v17, 8, v18
    v_and_b32 v19, 3, v0
    v_lshl_add_u32 v18, v19, 3, v18
    v_add_u32 v52, s63, v18
    v_xor_b32 v53, 32, v52
    v_xor_b32 v54, 64, v52
    v_xor_b32 v55, 96, v52
    s_mul_i32 s3, s7, 288
    s_add_u32 s3, s3, 137344
    v_lshlrev_b32 v18, 6, v17
    v_lshl_add_u32 v18, v16, 3, v18
    v_add_u32 v1, s3, v18
    v_and_b32 v18, 7, v0
    v_mul_u32_u24 v18, 288, v18
    v_lshl_add_u32 v18, v17, 4, v18
    v_add_u32 v56, 137344, v18
    v_and_b32_dpp v16, v46, v8 row_newbcast:0 row_mask:0xf bank_mask:0xf
    v_and_b32_dpp v17, v46, v9 row_newbcast:0 row_mask:0xf bank_mask:0xf
    v_and_b32_dpp v18, v46, v10 row_newbcast:0 row_mask:0xf bank_mask:0xf
    v_and_b32_dpp v19, v46, v11 row_newbcast:0 row_mask:0xf bank_mask:0xf
    v_and_b32_dpp v20, v46, v8 row_newbcast:8 row_mask:0xf bank_mask:0xf
    v_and_b32_dpp v21, v46, v9 row_newbcast:8 row_mask:0xf bank_mask:0xf
    v_and_b32_dpp v22, v46, v10 row_newbcast:8 row_mask:0xf bank_mask:0xf
    v_and_b32_dpp v23, v46, v11 row_newbcast:8 row_mask:0xf bank_mask:0xf
    v_and_b32_dpp v24, v46, v8 row_newbcast:4 row_mask:0xf bank_mask:0xf
    v_and_b32_dpp v25, v46, v9 row_newbcast:4 row_mask:0xf bank_mask:0xf
    v_and_b32_dpp v26, v46, v10 row_newbcast:4 row_mask:0xf bank_mask:0xf
    v_and_b32_dpp v27, v46, v11 row_newbcast:4 row_mask:0xf bank_mask:0xf
    v_and_b32_dpp v28, v46, v8 row_newbcast:12 row_mask:0xf bank_mask:0xf
    v_and_b32_dpp v29, v46, v9 row_newbcast:12 row_mask:0xf bank_mask:0xf
    v_and_b32_dpp v30, v46, v10 row_newbcast:12 row_mask:0xf bank_mask:0xf
    v_and_b32_dpp v31, v46, v11 row_newbcast:12 row_mask:0xf bank_mask:0xf
    s_waitcnt vmcnt(7)
    buffer_load_dwordx4 v[152:155], v2, s[16:19], s95 offen offset:512 nt
    s_waitcnt vmcnt(6)
    buffer_load_dwordx4 v[156:159], v2, s[16:19], s95 offen offset:768 nt
    s_add_u32 s68, s68, 0x2000
    s_add_u32 s69, s69, 0x400
    s_mov_b32 m0, s69
    s_nop 0
    buffer_load_dwordx4 v50, s[24:27], s68 offen  lds
    s_waitcnt vmcnt(7)
    buffer_load_dwordx4 v[160:163], v2, s[16:19], s96 offen offset:0 nt
    s_nop 0
    v_mfma_f32_16x16x32_bf16 v[12:15], v[128:131], v[16:19], 0
    v_mfma_f32_16x16x32_bf16 v[12:15], v[132:135], v[20:23], v[12:15]
    v_mfma_f32_16x16x32_bf16 v[12:15], v[136:139], v[24:27], v[12:15]
    v_mfma_f32_16x16x32_bf16 v[12:15], v[140:143], v[28:31], v[12:15]
    v_and_b32_dpp v16, v46, v8 row_newbcast:2 row_mask:0xf bank_mask:0xf
    v_and_b32_dpp v17, v46, v9 row_newbcast:2 row_mask:0xf bank_mask:0xf
    v_and_b32_dpp v18, v46, v10 row_newbcast:2 row_mask:0xf bank_mask:0xf
    v_and_b32_dpp v19, v46, v11 row_newbcast:2 row_mask:0xf bank_mask:0xf
    v_and_b32_dpp v20, v46, v8 row_newbcast:10 row_mask:0xf bank_mask:0xf
    v_and_b32_dpp v21, v46, v9 row_newbcast:10 row_mask:0xf bank_mask:0xf
    v_and_b32_dpp v22, v46, v10 row_newbcast:10 row_mask:0xf bank_mask:0xf
    v_and_b32_dpp v23, v46, v11 row_newbcast:10 row_mask:0xf bank_mask:0xf
    v_and_b32_dpp v24, v46, v8 row_newbcast:6 row_mask:0xf bank_mask:0xf
    v_and_b32_dpp v25, v46, v9 row_newbcast:6 row_mask:0xf bank_mask:0xf
    v_and_b32_dpp v26, v46, v10 row_newbcast:6 row_mask:0xf bank_mask:0xf
    v_and_b32_dpp v27, v46, v11 row_newbcast:6 row_mask:0xf bank_mask:0xf
    v_and_b32_dpp v28, v46, v8 row_newbcast:14 row_mask:0xf bank_mask:0xf
    v_and_b32_dpp v29, v46, v9 row_newbcast:14 row_mask:0xf bank_mask:0xf
    v_and_b32_dpp v30, v46, v10 row_newbcast:14 row_mask:0xf bank_mask:0xf
    v_and_b32_dpp v31, v46, v11 row_newbcast:14 row_mask:0xf bank_mask:0xf
    s_waitcnt vmcnt(6)
    buffer_load_dwordx4 v[164:167], v2, s[16:19], s96 offen offset:256 nt
    s_add_u32 s68, s68, 0x2000
    s_add_u32 s69, s69, 0x400
    s_mov_b32 m0, s69
    s_nop 0
    buffer_load_dwordx4 v51, s[24:27], s68 offen  lds
    s_waitcnt vmcnt(7)
    buffer_load_dwordx4 v[168:171], v2, s[16:19], s96 offen offset:512 nt
    s_waitcnt vmcnt(6)
    buffer_load_dwordx4 v[172:175], v2, s[16:19], s96 offen offset:768 nt
    s_lshl_b32 s3, s46, 15
    s_add_u32 s68, s62, s3
    s_lshl_b32 s3, s46, 12
    s_add_u32 s69, s63, s3
    s_mov_b32 m0, s69
    s_nop 0
    buffer_load_dwordx4 v48, s[24:27], s68 offen  lds
    s_waitcnt vmcnt(7)
    buffer_load_dwordx4 v[176:179], v2, s[16:19], s97 offen offset:0 nt
    s_nop 0
    v_mfma_f32_16x16x32_bf16 v[12:15], v[144:147], v[16:19], v[12:15]
    v_mfma_f32_16x16x32_bf16 v[12:15], v[148:151], v[20:23], v[12:15]
    v_mfma_f32_16x16x32_bf16 v[12:15], v[152:155], v[24:27], v[12:15]
    v_mfma_f32_16x16x32_bf16 v[12:15], v[156:159], v[28:31], v[12:15]
    s_cmp_lg_u32 s48, 0
    s_cbranch_scc1 L_nocl
    buffer_load_dword v3, off, s[32:35], s57 sc0 sc1
L_nocl:
    v_and_b32_dpp v16, v46, v8 row_newbcast:1 row_mask:0xf bank_mask:0xf
    v_and_b32_dpp v17, v46, v9 row_newbcast:1 row_mask:0xf bank_mask:0xf
    v_and_b32_dpp v18, v46, v10 row_newbcast:1 row_mask:0xf bank_mask:0xf
    v_and_b32_dpp v19, v46, v11 row_newbcast:1 row_mask:0xf bank_mask:0xf
    v_and_b32_dpp v20, v46, v8 row_newbcast:9 row_mask:0xf bank_mask:0xf
    v_and_b32_dpp v21, v46, v9 row_newbcast:9 row_mask:0xf bank_mask:0xf
    v_and_b32_dpp v22, v46, v10 row_newbcast:9 row_mask:0xf bank_mask:0xf
    v_and_b32_dpp v23, v46, v11 row_newbcast:9 row_mask:0xf bank_mask:0xf
    v_and_b32_dpp v24, v46, v8 row_newbcast:5 row_mask:0xf bank_mask:0xf
    v_and_b32_dpp v25, v46, v9 row_newbcast:5 row_mask:0xf bank_mask:0xf
    v_and_b32_dpp v26, v46, v10 row_newbcast:5 row_mask:0xf bank_mask:0xf
    v_and_b32_dpp v27, v46, v11 row_newbcast:5 row_mask:0xf bank_mask:0xf
    v_and_b32_dpp v28, v46, v8 row_newbcast:13 row_mask:0xf bank_mask:0xf
    v_and_b32_dpp v29, v46, v9 row_newbcast:13 row_mask:0xf bank_mask:0xf
    v_and_b32_dpp v30, v46, v10 row_newbcast:13 row_mask:0xf bank_mask:0xf
    v_and_b32_dpp v31, v46, v11 row_newbcast:13 row_mask:0xf bank_mask:0xf
    s_waitcnt vmcnt(6)
    buffer_load_dwordx4 v[180:183], v2, s[16:19], s97 offen offset:256 nt
    s_add_u32 s68, s68, 0x2000
    s_add_u32 s69, s69, 0x400
    s_mov_b32 m0, s69
    s_nop 0
    buffer_load_dwordx4 v49, s[24:27], s68 offen  lds
    s_waitcnt vmcnt(7)
    buffer_load_dwordx4 v[184:187], v2, s[16:19], s97 offen offset:512 nt
    s_waitcnt vmcnt(6)
    buffer_load_dwordx4 v[188:191], v2, s[16:19], s97 offen offset:768 nt
    s_add_u32 s68, s68, 0x2000
    s_add_u32 s69, s69, 0x400
    s_mov_b32 m0, s69
    s_nop 0
    buffer_load_dwordx4 v50, s[24:27], s68 offen  lds
    s_waitcnt vmcnt(7)
    buffer_load_dwordx4 v[192:195], v2, s[16:19], s98 offen offset:0 nt
    s_nop 0
    v_mfma_f32_16x16x32_bf16 v[12:15], v[160:163], v[16:19], v[12:15]
    v_mfma_f32_16x16x32_bf16 v[12:15], v[164:167], v[20:23], v[12:15]
    v_mfma_f32_16x16x32_bf16 v[12:15], v[168:171], v[24:27], v[12:15]
    v_mfma_f32_16x16x32_bf16 v[12:15], v[172:175], v[28:31], v[12:15]
    v_and_b32_dpp v16, v46, v8 row_newbcast:3 row_mask:0xf bank_mask:0xf
    v_and_b32_dpp v17, v46, v9 row_newbcast:3 row_mask:0xf bank_mask:0xf
    v_and_b32_dpp v18, v46, v10 row_newbcast:3 row_mask:0xf bank_mask:0xf
    v_and_b32_dpp v19, v46, v11 row_newbcast:3 row_mask:0xf bank_mask:0xf
    v_and_b32_dpp v20, v46, v8 row_newbcast:11 row_mask:0xf bank_mask:0xf
    v_and_b32_dpp v21, v46, v9 row_newbcast:11 row_mask:0xf bank_mask:0xf
    v_and_b32_dpp v22, v46, v10 row_newbcast:11 row_mask:0xf bank_mask:0xf
    v_and_b32_dpp v23, v46, v11 row_newbcast:11 row_mask:0xf bank_mask:0xf
    v_and_b32_dpp v24, v46, v8 row_newbcast:7 row_mask:0xf bank_mask:0xf
    v_and_b32_dpp v25, v46, v9 row_newbcast:7 row_mask:0xf bank_mask:0xf
    v_and_b32_dpp v26, v46, v10 row_newbcast:7 row_mask:0xf bank_mask:0xf
    v_and_b32_dpp v27, v46, v11 row_newbcast:7 row_mask:0xf bank_mask:0xf
    v_and_b32_dpp v28, v46, v8 row_newbcast:15 row_mask:0xf bank_mask:0xf
    v_and_b32_dpp v29, v46, v9 row_newbcast:15 row_mask:0xf bank_mask:0xf
    v_and_b32_dpp v30, v46, v10 row_newbcast:15 row_mask:0xf bank_mask:0xf
    v_and_b32_dpp v31, v46, v11 row_newbcast:15 row_mask:0xf bank_mask:0xf
    s_waitcnt vmcnt(6)
    buffer_load_dwordx4 v[196:199], v2, s[16:19], s98 offen offset:256 nt
    s_add_u32 s68, s68, 0x2000
    s_add_u32 s69, s69, 0x400
    s_mov_b32 m0, s69
    s_nop 0
    buffer_load_dwordx4 v51, s[24:27], s68 offen  lds
    s_waitcnt vmcnt(7)
    buffer_load_dwordx4 v[200:203], v2, s[16:19], s98 offen offset:512 nt
    s_waitcnt vmcnt(6)
    buffer_load_dwordx4 v[204:207], v2, s[16:19], s98 offen offset:768 nt
    s_lshl_b32 s3, s47, 15
    s_add_u32 s68, s62, s3
    s_lshl_b32 s3, s47, 12
    s_add_u32 s69, s63, s3
    s_mov_b32 m0, s69
    s_nop 0
    buffer_load_dwordx4 v48, s[24:27], s68 offen  lds
    s_waitcnt vmcnt(7)
    buffer_load_dwordx4 v[208:211], v2, s[16:19], s99 offen offset:0 nt
    s_nop 0
    v_mfma_f32_16x16x32_bf16 v[12:15], v[176:179], v[16:19], v[12:15]
    v_mfma_f32_16x16x32_bf16 v[12:15], v[180:183], v[20:23], v[12:15]
    v_mfma_f32_16x16x32_bf16 v[12:15], v[184:187], v[24:27], v[12:15]
    v_mfma_f32_16x16x32_bf16 v[12:15], v[188:191], v[28:31], v[12:15]
    v_and_b32_dpp v16, v47, v8 row_newbcast:0 row_mask:0xf bank_mask:0xf
    v_and_b32_dpp v17, v47, v9 row_newbcast:0 row_mask:0xf bank_mask:0xf
    v_and_b32_dpp v18, v47, v10 row_newbcast:0 row_mask:0xf bank_mask:0xf
    v_and_b32_dpp v19, v47, v11 row_newbcast:0 row_mask:0xf bank_mask:0xf
    v_and_b32_dpp v20, v47, v8 row_newbcast:8 row_mask:0xf bank_mask:0xf
    v_and_b32_dpp v21, v47, v9 row_newbcast:8 row_mask:0xf bank_mask:0xf
    v_and_b32_dpp v22, v47, v10 row_newbcast:8 row_mask:0xf bank_mask:0xf
    v_and_b32_dpp v23, v47, v11 row_newbcast:8 row_mask:0xf bank_mask:0xf
    v_and_b32_dpp v24, v47, v8 row_newbcast:4 row_mask:0xf bank_mask:0xf
    v_and_b32_dpp v25, v47, v9 row_newbcast:4 row_mask:0xf bank_mask:0xf
    v_and_b32_dpp v26, v47, v10 row_newbcast:4 row_mask:0xf bank_mask:0xf
    v_and_b32_dpp v27, v47, v11 row_newbcast:4 row_mask:0xf bank_mask:0xf
    v_and_b32_dpp v28, v47, v8 row_newbcast:12 row_mask:0xf bank_mask:0xf
    v_and_b32_dpp v29, v47, v9 row_newbcast:12 row_mask:0xf bank_mask:0xf
    v_and_b32_dpp v30, v47, v10 row_newbcast:12 row_mask:0xf bank_mask:0xf
    v_and_b32_dpp v31, v47, v11 row_newbcast:12 row_mask:0xf bank_mask:0xf
    s_waitcnt vmcnt(7)
    buffer_load_dwordx4 v[212:215], v2, s[16:19], s99 offen offset:256 nt
    s_add_u32 s68, s68, 0x2000
    s_add_u32 s69, s69, 0x400
    s_mov_b32 m0, s69
    s_nop 0
    buffer_load_dwordx4 v49, s[24:27], s68 offen  lds
    s_waitcnt vmcnt(8)
    buffer_load_dwordx4 v[216:219], v2, s[16:19], s99 offen offset:512 nt
    s_waitcnt vmcnt(8)
    buffer_load_dwordx4 v[220:223], v2, s[16:19], s99 offen offset:768 nt
    s_add_u32 s68, s68, 0x2000
    s_add_u32 s69, s69, 0x400
    s_mov_b32 m0, s69
    s_nop 0
    buffer_load_dwordx4 v50, s[24:27], s68 offen  lds
    s_waitcnt vmcnt(8)
    buffer_load_dwordx4 v[224:227], v2, s[16:19], s100 offen offset:0 nt
    s_waitcnt vmcnt(8)
    buffer_load_dwordx4 v[228:231], v2, s[16:19], s100 offen offset:256 nt
    s_nop 0
    v_mfma_f32_16x16x32_bf16 v[12:15], v[192:195], v[16:19], v[12:15]
    v_mfma_f32_16x16x32_bf16 v[12:15], v[196:199], v[20:23], v[12:15]
    v_mfma_f32_16x16x32_bf16 v[12:15], v[200:203], v[24:27], v[12:15]
    v_mfma_f32_16x16x32_bf16 v[12:15], v[204:207], v[28:31], v[12:15]
    v_and_b32_dpp v16, v47, v8 row_newbcast:2 row_mask:0xf bank_mask:0xf
    v_and_b32_dpp v17, v47, v9 row_newbcast:2 row_mask:0xf bank_mask:0xf
    v_and_b32_dpp v18, v47, v10 row_newbcast:2 row_mask:0xf bank_mask:0xf
    v_and_b32_dpp v19, v47, v11 row_newbcast:2 row_mask:0xf bank_mask:0xf
    v_and_b32_dpp v20, v47, v8 row_newbcast:10 row_mask:0xf bank_mask:0xf
    v_and_b32_dpp v21, v47, v9 row_newbcast:10 row_mask:0xf bank_mask:0xf
    v_and_b32_dpp v22, v47, v10 row_newbcast:10 row_mask:0xf bank_mask:0xf
    v_and_b32_dpp v23, v47, v11 row_newbcast:10 row_mask:0xf bank_mask:0xf
    v_and_b32_dpp v24, v47, v8 row_newbcast:6 row_mask:0xf bank_mask:0xf
    v_and_b32_dpp v25, v47, v9 row_newbcast:6 row_mask:0xf bank_mask:0xf
    v_and_b32_dpp v26, v47, v10 row_newbcast:6 row_mask:0xf bank_mask:0xf
    v_and_b32_dpp v27, v47, v11 row_newbcast:6 row_mask:0xf bank_mask:0xf
    v_and_b32_dpp v28, v47, v8 row_newbcast:14 row_mask:0xf bank_mask:0xf
    v_and_b32_dpp v29, v47, v9 row_newbcast:14 row_mask:0xf bank_mask:0xf
    v_and_b32_dpp v30, v47, v10 row_newbcast:14 row_mask:0xf bank_mask:0xf
    v_and_b32_dpp v31, v47, v11 row_newbcast:14 row_mask:0xf bank_mask:0xf
    s_add_u32 s68, s68, 0x2000
    s_add_u32 s69, s69, 0x400
    s_mov_b32 m0, s69
    s_nop 0
    buffer_load_dwordx4 v51, s[24:27], s68 offen  lds
    s_waitcnt vmcnt(8)
    buffer_load_dwordx4 v[232:235], v2, s[16:19], s100 offen offset:512 nt
    s_waitcnt vmcnt(8)
    buffer_load_dwordx4 v[236:239], v2, s[16:19], s100 offen offset:768 nt
    buffer_load_dwordx4 v[240:243], v2, s[16:19], s101 offen offset:0 nt
    s_waitcnt vmcnt(8)
    buffer_load_dwordx4 v[244:247], v2, s[16:19], s101 offen offset:256 nt
    s_waitcnt vmcnt(8)
    buffer_load_dwordx4 v[248:251], v2, s[16:19], s101 offen offset:512 nt
    s_nop 0
    v_mfma_f32_16x16x32_bf16 v[12:15], v[208:211], v[16:19], v[12:15]
    v_mfma_f32_16x16x32_bf16 v[12:15], v[212:215], v[20:23], v[12:15]
    v_mfma_f32_16x16x32_bf16 v[12:15], v[216:219], v[24:27], v[12:15]
    v_mfma_f32_16x16x32_bf16 v[12:15], v[220:223], v[28:31], v[12:15]
    s_cmp_lg_u32 s48, 0
    s_cbranch_scc1 L_cntok
    s_mov_b32 s42, 0x40000
L_cpoll:
    v_cmp_le_u32 vcc, 0x80, v3
    s_cbranch_vccnz L_cntok
    buffer_load_dword v3, off, s[32:35], s57 sc0 sc1
    s_sub_u32 s42, s42, 1
    s_cmp_lg_u32 s42, 0
    s_waitcnt vmcnt(0)
    s_cbranch_scc1 L_cpoll
L_cntok:
    v_and_b32_dpp v16, v47, v8 row_newbcast:1 row_mask:0xf bank_mask:0xf
    v_and_b32_dpp v17, v47, v9 row_newbcast:1 row_mask:0xf bank_mask:0xf
    v_and_b32_dpp v18, v47, v10 row_newbcast:1 row_mask:0xf bank_mask:0xf
    v_and_b32_dpp v19, v47, v11 row_newbcast:1 row_mask:0xf bank_mask:0xf
    v_and_b32_dpp v20, v47, v8 row_newbcast:9 row_mask:0xf bank_mask:0xf
    v_and_b32_dpp v21, v47, v9 row_newbcast:9 row_mask:0xf bank_mask:0xf
    v_and_b32_dpp v22, v47, v10 row_newbcast:9 row_mask:0xf bank_mask:0xf
    v_and_b32_dpp v23, v47, v11 row_newbcast:9 row_mask:0xf bank_mask:0xf
    v_and_b32_dpp v24, v47, v8 row_newbcast:5 row_mask:0xf bank_mask:0xf
    v_and_b32_dpp v25, v47, v9 row_newbcast:5 row_mask:0xf bank_mask:0xf
    v_and_b32_dpp v26, v47, v10 row_newbcast:5 row_mask:0xf bank_mask:0xf
    v_and_b32_dpp v27, v47, v11 row_newbcast:5 row_mask:0xf bank_mask:0xf
    v_and_b32_dpp v28, v47, v8 row_newbcast:13 row_mask:0xf bank_mask:0xf
    v_and_b32_dpp v29, v47, v9 row_newbcast:13 row_mask:0xf bank_mask:0xf
    v_and_b32_dpp v30, v47, v10 row_newbcast:13 row_mask:0xf bank_mask:0xf
    v_and_b32_dpp v31, v47, v11 row_newbcast:13 row_mask:0xf bank_mask:0xf
    s_waitcnt vmcnt(7)
    buffer_load_dwordx4 v[252:255], v2, s[16:19], s101 offen offset:768 nt
    s_waitcnt vmcnt(6)
    ds_read_b64_tr_b16 v[64:65], v52 offset:0
    ds_read_b64_tr_b16 v[66:67], v52 offset:128
    ds_read_b64_tr_b16 v[68:69], v52 offset:4096
    ds_read_b64_tr_b16 v[70:71], v52 offset:4224
    ds_read_b64_tr_b16 v[72:73], v52 offset:8192
    ds_read_b64_tr_b16 v[74:75], v52 offset:8320
    ds_read_b64_tr_b16 v[76:77], v52 offset:12288
    ds_read_b64_tr_b16 v[78:79], v52 offset:12416
    s_waitcnt lgkmcnt(4)
    ds_read_b64_tr_b16 v[80:81], v53 offset:0
    ds_read_b64_tr_b16 v[82:83], v53 offset:128
    ds_read_b64_tr_b16 v[84:85], v53 offset:4096
    ds_read_b64_tr_b16 v[86:87], v53 offset:4224
    ds_read_b64_tr_b16 v[88:89], v53 offset:8192
    ds_read_b64_tr_b16 v[90:91], v53 offset:8320
    ds_read_b64_tr_b16 v[92:93], v53 offset:12288
    ds_read_b64_tr_b16 v[94:95], v53 offset:12416
    s_waitcnt lgkmcnt(4)
    ds_read_b64_tr_b16 v[96:97], v54 offset:0
    ds_read_b64_tr_b16 v[98:99], v54 offset:128
    ds_read_b64_tr_b16 v[100:101], v54 offset:4096
    ds_read_b64_tr_b16 v[102:103], v54 offset:4224
    ds_read_b64_tr_b16 v[104:105], v54 offset:8192
    ds_read_b64_tr_b16 v[106:107], v54 offset:8320
    ds_read_b64_tr_b16 v[108:109], v54 offset:12288
    ds_read_b64_tr_b16 v[110:111], v54 offset:12416
    s_waitcnt lgkmcnt(4)
    ds_read_b64_tr_b16 v[112:113], v55 offset:0
    ds_read_b64_tr_b16 v[114:115], v55 offset:128
    ds_read_b64_tr_b16 v[116:117], v55 offset:4096
    ds_read_b64_tr_b16 v[118:119], v55 offset:4224
    ds_read_b64_tr_b16 v[120:121], v55 offset:8192
    ds_read_b64_tr_b16 v[122:123], v55 offset:8320
    ds_read_b64_tr_b16 v[124:125], v55 offset:12288
    ds_read_b64_tr_b16 v[126:127], v55 offset:12416
    s_waitcnt lgkmcnt(4)
    s_waitcnt vmcnt(4)
    s_nop 0
    v_mfma_f32_16x16x32_bf16 v[12:15], v[224:227], v[16:19], v[12:15]
    v_mfma_f32_16x16x32_bf16 v[12:15], v[228:231], v[20:23], v[12:15]
    v_mfma_f32_16x16x32_bf16 v[12:15], v[232:235], v[24:27], v[12:15]
    v_mfma_f32_16x16x32_bf16 v[12:15], v[236:239], v[28:31], v[12:15]
    v_and_b32_dpp v16, v47, v8 row_newbcast:3 row_mask:0xf bank_mask:0xf
    v_and_b32_dpp v17, v47, v9 row_newbcast:3 row_mask:0xf bank_mask:0xf
    v_and_b32_dpp v18, v47, v10 row_newbcast:3 row_mask:0xf bank_mask:0xf
    v_and_b32_dpp v19, v47, v11 row_newbcast:3 row_mask:0xf bank_mask:0xf
    v_and_b32_dpp v20, v47, v8 row_newbcast:11 row_mask:0xf bank_mask:0xf
    v_and_b32_dpp v21, v47, v9 row_newbcast:11 row_mask:0xf bank_mask:0xf
    v_and_b32_dpp v22, v47, v10 row_newbcast:11 row_mask:0xf bank_mask:0xf
    v_and_b32_dpp v23, v47, v11 row_newbcast:11 row_mask:0xf bank_mask:0xf
    v_and_b32_dpp v24, v47, v8 row_newbcast:7 row_mask:0xf bank_mask:0xf
    v_and_b32_dpp v25, v47, v9 row_newbcast:7 row_mask:0xf bank_mask:0xf
    v_and_b32_dpp v26, v47, v10 row_newbcast:7 row_mask:0xf bank_mask:0xf
    v_and_b32_dpp v27, v47, v11 row_newbcast:7 row_mask:0xf bank_mask:0xf
    v_and_b32_dpp v28, v47, v8 row_newbcast:15 row_mask:0xf bank_mask:0xf
    v_and_b32_dpp v29, v47, v9 row_newbcast:15 row_mask:0xf bank_mask:0xf
    v_and_b32_dpp v30, v47, v10 row_newbcast:15 row_mask:0xf bank_mask:0xf
    v_and_b32_dpp v31, v47, v11 row_newbcast:15 row_mask:0xf bank_mask:0xf
    s_waitcnt vmcnt(0)
    s_nop 0
    v_mfma_f32_16x16x32_bf16 v[12:15], v[240:243], v[16:19], v[12:15]
    v_mfma_f32_16x16x32_bf16 v[12:15], v[244:247], v[20:23], v[12:15]
    v_mfma_f32_16x16x32_bf16 v[12:15], v[248:251], v[24:27], v[12:15]
    v_mfma_f32_16x16x32_bf16 v[12:15], v[252:255], v[28:31], v[12:15]
    s_nop 7
    v_cvt_pk_bf16_f32 v12, v12, v13
    v_cvt_pk_bf16_f32 v13, v14, v15
    s_mov_b64 exec, s[66:67]
    ds_write_b64 v1, v[12:13]
    s_mov_b64 exec, -1
    s_waitcnt lgkmcnt(0)
    s_barrier
    ds_read_b128 v[48:51], v7
    ds_read_b128 v[52:55], v7 offset:32
    ds_read_b128 v[16:19], v56 offset:0
    ds_read_b128 v[20:23], v56 offset:64
    ds_read_b128 v[24:27], v56 offset:128
    ds_read_b128 v[28:31], v56 offset:192
    s_waitcnt lgkmcnt(3)
    v_mfma_f32_16x16x32_bf16 v[32:35], v[16:19], v[64:67], 0
    v_mfma_f32_16x16x32_bf16 v[36:39], v[16:19], v[80:83], 0
    v_mfma_f32_16x16x32_bf16 v[40:43], v[16:19], v[96:99], 0
    v_mfma_f32_16x16x32_bf16 v[44:47], v[16:19], v[112:115], 0
    v_max3_f32 v56, v48, v49, v50
    v_max_f32 v56, v56, v51
    v_mov_b32 v57, v56
    s_waitcnt lgkmcnt(2)
    v_mfma_f32_16x16x32_bf16 v[32:35], v[20:23], v[68:71], v[32:35]
    v_mfma_f32_16x16x32_bf16 v[36:39], v[20:23], v[84:87], v[36:39]
    v_mfma_f32_16x16x32_bf16 v[40:43], v[20:23], v[100:103], v[40:43]
    v_mfma_f32_16x16x32_bf16 v[44:47], v[20:23], v[116:119], v[44:47]
    v_permlane16_swap_b32 v56, v57
    v_max_f32 v56, v56, v57
    v_sub_f32 v48, v48, v56
    v_sub_f32 v49, v49, v56
    v_sub_f32 v50, v50, v56
    v_sub_f32 v51, v51, v56
    s_waitcnt lgkmcnt(1)
    v_mfma_f32_16x16x32_bf16 v[32:35], v[24:27], v[72:75], v[32:35]
    v_mfma_f32_16x16x32_bf16 v[36:39], v[24:27], v[88:91], v[36:39]
    v_mfma_f32_16x16x32_bf16 v[40:43], v[24:27], v[104:107], v[40:43]
    v_mfma_f32_16x16x32_bf16 v[44:47], v[24:27], v[120:123], v[44:47]
    v_exp_f32 v48, v48
    v_exp_f32 v49, v49
    v_exp_f32 v50, v50
    v_exp_f32 v51, v51
    s_waitcnt lgkmcnt(0)
    v_mfma_f32_16x16x32_bf16 v[32:35], v[28:31], v[76:79], v[32:35]
    v_mfma_f32_16x16x32_bf16 v[36:39], v[28:31], v[92:95], v[36:39]
    v_mfma_f32_16x16x32_bf16 v[40:43], v[28:31], v[108:111], v[40:43]
    v_mfma_f32_16x16x32_bf16 v[44:47], v[28:31], v[124:127], v[44:47]
    v_mul_f32 v57, v48, v52
    v_fma_f32 v57, v49, v53, v57
    v_fma_f32 v57, v50, v54, v57
    v_fma_f32 v57, v51, v55, v57
    v_mov_b32 v58, v57
    v_mul_f32 v32, v32, v48
    v_mul_f32 v36, v36, v48
    v_permlane16_swap_b32 v57, v58
    v_add_f32 v57, v57, v58
    v_mul_f32 v40, v40, v48
    v_mul_f32 v44, v44, v48
    v_fma_f32 v32, v33, v49, v32
    v_fma_f32 v36, v37, v49, v36
    v_fma_f32 v40, v41, v49, v40
    v_fma_f32 v44, v45, v49, v44
    v_fma_f32 v32, v34, v50, v32
    v_fma_f32 v36, v38, v50, v36
    v_fma_f32 v40, v42, v50, v40
    v_fma_f32 v44, v46, v50, v44
    v_fma_f32 v32, v35, v51, v32
    v_fma_f32 v36, v39, v51, v36
    v_fma_f32 v40, v43, v51, v40
    v_fma_f32 v44, v47, v51, v44
    v_min_u32 v56, -2, v56
    v_min_u32 v57, -2, v57
    v_permlane16_swap_b32 v32, v36
    v_permlane16_swap_b32 v40, v44
    v_add_f32 v32, v32, v36
    v_add_f32 v40, v40, v44
    s_nop 1
    v_permlane32_swap_b32 v32, v40
    v_min_u32 v32, -2, v32
    s_nop 1
    v_mov_b32_dpp v33, v32 quad_perm:[1,1,1,1] row_mask:0xf bank_mask:0xf
    v_mov_b32_dpp v34, v32 quad_perm:[2,2,2,2] row_mask:0xf bank_mask:0xf
    v_mov_b32_dpp v35, v32 quad_perm:[3,3,3,3] row_mask:0xf bank_mask:0xf
    s_mov_b64 exec, s[60:61]
    buffer_store_dwordx4 v[32:35], v5, s[36:39], s58 offen sc0 sc1
    s_cmp_lg_u32 s7, 0
    s_cbranch_scc1 L_noml
    s_mov_b64 exec, 1
    buffer_store_dwordx2 v[56:57], off, s[36:39], s59 sc0 sc1
L_noml:
    s_mov_b64 exec, -1
    s_cmp_lg_u32 s56, 0
    s_cbranch_scc1 L_fin
    s_lshl_b32 s40, s6, 18
    s_lshl_b32 s3, s49, 14
    s_add_u32 s40, s40, s3
    s_lshl_b32 s3, s7, 11
    s_add_u32 s40, s40, s3
    s_lshl_b32 s41, s6, 10
    s_lshl_b32 s3, s7, 7
    s_add_u32 s41, s41, s3
    s_add_u32 s41, s41, 524288
    v_lshlrev_b32 v1, 4, v0
    v_lshrrev_b32 v3, 3, v0
    v_lshlrev_b32 v3, 3, v3
    s_mov_b32 s42, 0x40000
L_poll:
    buffer_load_dwordx4 v[16:19], v1, s[36:39], s40 offen sc0 sc1
    buffer_load_dwordx4 v[20:23], v1, s[36:39], s40 offen offset:1024 sc0 sc1
    buffer_load_dwordx2 v[24:25], v3, s[36:39], s41 offen sc0 sc1
    buffer_load_dwordx2 v[26:27], v3, s[36:39], s41 offen offset:64 sc0 sc1
    s_sub_u32 s42, s42, 1
    s_waitcnt vmcnt(0)
    v_max3_u32 v28, v16, v17, v18
    v_max3_u32 v29, v19, v20, v21
    v_max3_u32 v28, v28, v22, v23
    v_max3_u32 v29, v29, v24, v25
    v_max3_u32 v28, v28, v26, v27
    v_max_u32 v28, v28, v29
    v_cmp_eq_u32 vcc, -1, v28
    s_cbranch_vccz L_got
    s_cmp_gt_i32 s42, 0
    s_cbranch_scc1 L_poll
L_got:
    v_max_f32_dpp v28, v24, v24 row_ror:8 row_mask:0xf bank_mask:0xf
    v_max_f32_dpp v30, v26, v26 row_ror:8 row_mask:0xf bank_mask:0xf
    v_mov_b32 v29, v28
    v_mov_b32 v31, v30
    s_nop 0
    v_permlane16_swap_b32 v28, v29
    v_permlane16_swap_b32 v30, v31
    v_max_f32 v28, v28, v29
    v_max_f32 v30, v30, v31
    v_sub_f32 v24, v24, v28
    v_sub_f32 v26, v26, v30
    v_exp_f32 v24, v24
    v_exp_f32 v26, v26
    s_nop 0
    v_mul_f32 v25, v24, v25
    v_mul_f32 v27, v26, v27
    s_nop 0
    v_add_f32_dpp v28, v25, v25 row_ror:8 row_mask:0xf bank_mask:0xf
    v_add_f32_dpp v30, v27, v27 row_ror:8 row_mask:0xf bank_mask:0xf
    v_mov_b32 v29, v28
    v_mov_b32 v31, v30
    s_nop 0
    v_permlane16_swap_b32 v28, v29
    v_permlane16_swap_b32 v30, v31
    v_add_f32 v28, v28, v29
    v_add_f32 v30, v30, v31
    v_rcp_f32 v28, v28
    v_rcp_f32 v30, v30
    s_nop 0
    v_mul_f32 v24, v24, v28
    v_mul_f32 v26, v26, v30
    v_mul_f32 v16, v16, v24
    v_mul_f32 v17, v17, v24
    v_mul_f32 v18, v18, v24
    v_mul_f32 v19, v19, v24
    v_fma_f32 v16, v20, v26, v16
    v_fma_f32 v17, v21, v26, v17
    v_fma_f32 v18, v22, v26, v18
    v_fma_f32 v19, v23, v26, v19
    v_and_b32 v28, 7, v0
    v_lshrrev_b32 v29, 4, v0
    v_add_f32_dpp v16, v16, v16 row_ror:8 row_mask:0xf bank_mask:0xf
    v_add_f32_dpp v17, v17, v17 row_ror:8 row_mask:0xf bank_mask:0xf
    v_add_f32_dpp v18, v18, v18 row_ror:8 row_mask:0xf bank_mask:0xf
    v_add_f32_dpp v19, v19, v19 row_ror:8 row_mask:0xf bank_mask:0xf
    v_lshl_add_u32 v28, v28, 2, v29
    s_lshl_b32 s3, s7, 2
    s_add_u32 s3, s3, 139648
    v_permlane16_swap_b32 v16, v17
    v_permlane16_swap_b32 v18, v19
    v_add_f32 v16, v16, v17
    v_add_f32 v18, v18, v19
    v_lshl_add_u32 v28, v28, 5, s3
    s_nop 0
    v_permlane32_swap_b32 v16, v18
    v_add_f32 v16, v16, v18
    ds_write_b32 v28, v16
    s_waitcnt lgkmcnt(0)
    s_barrier
    s_cmp_lg_u32 s7, 0
    s_cbranch_scc1 L_fin
    v_and_b32 v1, 31, v0
    v_lshlrev_b32 v2, 5, v1
    v_add_u32 v2, 139648, v2
    ds_read_b128 v[16:19], v2
    ds_read_b128 v[20:23], v2 offset:16
    v_lshlrev_b32 v1, 1, v1
    s_lshl_b32 s40, s6, 10
    s_lshl_b32 s3, s49, 6
    s_add_u32 s40, s40, s3
    s_waitcnt lgkmcnt(0)
    v_add_f32 v16, v16, v17
    v_add_f32 v18, v18, v19
    v_add_f32 v20, v20, v21
    v_add_f32 v22, v22, v23
    v_add_f32 v16, v16, v18
    v_add_f32 v20, v20, v22
    v_add_f32 v16, v16, v20
    v_cvt_pk_bf16_f32 v16, v16, v16
    buffer_store_short v16, v1, s[28:31], s40 offen
L_fin:
L_end:
s_endpgm
.section .rodata,"a"
.p2align 6
.amdhsa_kernel concat_heads__gqa_block_cached__gqa_block_cached__decode_kernel
  .amdhsa_next_free_vgpr 256
  .amdhsa_next_free_sgpr 102
  .amdhsa_accum_offset 256
  .amdhsa_group_segment_fixed_size 0
  .amdhsa_kernarg_size 104
  .amdhsa_user_sgpr_count 2
  .amdhsa_user_sgpr_kernarg_segment_ptr 1
  .amdhsa_system_sgpr_workgroup_id_x 1
.end_amdhsa_kernel
```
